```python
import torch

def _softmax(x, axis=-1):
    return torch.softmax(x, dim=axis)
def _gelu(x):
    return torch.nn.functional.gelu(x, approximate="tanh")
def _silu(x):
    return torch.nn.functional.silu(x)
def _sigmoid(x):
    return torch.sigmoid(x)
def _layernorm(x, axis=-1, eps=1e-5):
    m = x.mean(dim=axis, keepdim=True)
    v = x.var(dim=axis, keepdim=True, unbiased=False)
    return (x - m) / torch.sqrt(v + eps)
def _scatter_add(tgt, idx, src, axis=0):
    return tgt.clone().index_add_(axis, idx, src)
def _segment_sum(src, seg, n):
    out = torch.zeros((n,) + src.shape[1:], dtype=src.dtype)
    return out.index_add_(0, seg, src)
def _pad(x, pw):
    flat = tuple(v for pair in reversed(pw) for v in pair)
    return torch.nn.functional.pad(x, flat)

kernel_name = 'concat_heads__gqa_block_cached__sliding_block_cached__decode'

def setup_inputs():

    _w = (lambda a: (lambda t: t.to(torch.bfloat16) if t.is_floating_point() else t)(torch.as_tensor(a)))
    def _A_setup():
        B, Sq, D = 2, 1, 512
        Hq, Hkv, Sk, Dh = 32, 8, 32768, 128
        assert Hq % Hkv == 0, (Hq, Hkv)
        return {
            "x": _w((lambda *s: torch.randn(*s, dtype=torch.bfloat16) * 1.6)(B, Sq, D)),
            "k_cache": _w((lambda *s: torch.randn(*s, dtype=torch.bfloat16) * 1.6)(B, Hkv, Sk, Dh)),
            "v_cache": _w((lambda *s: torch.randn(*s, dtype=torch.bfloat16) * 0.05)(B, Hkv, Sk, Dh)),
            "wq": _w((lambda *s: torch.randn(*s, dtype=torch.bfloat16) * 1.6)(D, Hq * Dh) * (D ** -0.5)),
            "wo": _w((lambda *s: torch.randn(*s, dtype=torch.bfloat16) * 0.05)(Hq * Dh, D) * ((Hq * Dh) ** -0.5)),
        }
    _A_in = _A_setup()

    def _B_setup():
        B, Sq, D = 2, 1, 512
        Hq, Hkv, Sk, Dh = 32, 8, 32768, 128
        assert Hq % Hkv == 0, (Hq, Hkv)
        return {
            "x": _w((lambda *s: torch.randn(*s, dtype=torch.bfloat16) * 1.6)(B, Sq, D)),
            "k_cache": _w((lambda *s: torch.randn(*s, dtype=torch.bfloat16) * 1.6)(B, Hkv, Sk, Dh)),
            "v_cache": _w((lambda *s: torch.randn(*s, dtype=torch.bfloat16) * 0.05)(B, Hkv, Sk, Dh)),
            "wq": _w((lambda *s: torch.randn(*s, dtype=torch.bfloat16) * 1.6)(D, Hq * Dh) * (D ** -0.5)),
            "wo": _w((lambda *s: torch.randn(*s, dtype=torch.bfloat16) * 0.05)(Hq * Dh, D) * ((Hq * Dh) ** -0.5)),
        }
    _B_in = _B_setup()

    return {
        "A_x": _A_in["x"],
        "A_k_cache": _A_in["k_cache"],
        "A_v_cache": _A_in["v_cache"],
        "A_wq": _A_in["wq"],
        "A_wo": _A_in["wo"],
        "B_x": _B_in["x"],
        "B_k_cache": _B_in["k_cache"],
        "B_v_cache": _B_in["v_cache"],
        "B_wq": _B_in["wq"],
        "B_wo": _B_in["wo"],
    }

def reference(A_x, A_k_cache, A_v_cache, A_wq, A_wo, B_x, B_k_cache, B_v_cache, B_wq, B_wo):
    def _A_ref(x, k_cache, v_cache, wq, wo):
        B, Sq, D = x.shape
        Hq, Dh = 32, 128
        Hkv = k_cache.shape[1]
        rep = Hq // Hkv
        q = (lambda x, *d: x.permute(*d))((x @ wq).reshape(B, Sq, Hq, Dh), 0, 2, 1, 3)
        k = (lambda x, n, axis: torch.repeat_interleave(x, n, dim=axis))(k_cache, rep, axis=1)
        v = (lambda x, n, axis: torch.repeat_interleave(x, n, dim=axis))(v_cache, rep, axis=1)
        scores = torch.einsum("bhqd,bhkd->bhqk", q, k) * (Dh ** -0.5)
        p = _softmax(scores, axis=-1)
        o = torch.einsum("bhqk,bhkd->bhqd", p, v)
        return (lambda x, *d: x.permute(*d))(o, 0, 2, 1, 3).reshape(B, Sq, Hq * Dh) @ wo

    def _B_ref(x, k_cache, v_cache, wq, wo):
        B, Sq, D = x.shape
        Hq, Dh = 32, 128
        Hkv, Sk = k_cache.shape[1], k_cache.shape[2]
        W = min(4096, max(256, Sk // 4))
        rep = Hq // Hkv
        q = (lambda x, *d: x.permute(*d))((x @ wq).reshape(B, Sq, Hq, Dh), 0, 2, 1, 3)
        k = (lambda x, n, axis: torch.repeat_interleave(x, n, dim=axis))(k_cache[:, :, Sk - W:, :], rep, axis=1)
        v = (lambda x, n, axis: torch.repeat_interleave(x, n, dim=axis))(v_cache[:, :, Sk - W:, :], rep, axis=1)
        scores = torch.einsum("bhqd,bhkd->bhqk", q, k) * (Dh ** -0.5)
        p = _softmax(scores, axis=-1)
        o = torch.einsum("bhqk,bhkd->bhqd", p, v)
        return (lambda x, *d: x.permute(*d))(o, 0, 2, 1, 3).reshape(B, Sq, Hq * Dh) @ wo

    a = _A_ref(A_x, A_k_cache, A_v_cache, A_wq, A_wo)
    b = _B_ref(B_x, B_k_cache, B_v_cache, B_wq, B_wo)
    return torch.concatenate([a, b], axis=-1)
```

```asm
; @launch grid=(256,1,1) block=(256,1,1) lds=86016
.amdgcn_target "amdgcn-amd-amdhsa--gfx950"
.text
.globl concat_heads__gqa_block_cached__sliding_block_cached__decode_kernel
.p2align 8
.type concat_heads__gqa_block_cached__sliding_block_cached__decode_kernel,@function
concat_heads__gqa_block_cached__sliding_block_cached__decode_kernel:
  s_cmp_ge_u32 s2, 256
  s_cbranch_scc1 L_end
  s_load_dwordx16 s[4:19], s[0:1], 0
  s_load_dwordx8 s[20:27], s[0:1], 64
  s_load_dwordx2 s[28:29], s[0:1], 96
  v_lshrrev_b32 v4, 6, v0
  v_and_b32 v1, 63, v0
  v_readfirstlane_b32 s3, v4
  s_lshr_b32 s30, s2, 4
  s_and_b32 s31, s2, 15
  s_lshr_b32 s40, s30, 3
  s_and_b32 s41, s30, 7
  v_and_b32 v4, 15, v1
  v_lshrrev_b32 v5, 4, v1
  v_lshlrev_b32 v3, 4, v1
  v_mov_b32 v22, 0
  v_mov_b32 v23, 0
  v_mov_b32 v29, 71168
  s_cmp_lg_u32 s3, 0
  s_cbranch_scc1 L_noinit
  v_mov_b32 v8, 0
  v_mov_b32 v9, 0
  v_mov_b32 v10, 0
  v_mov_b32 v11, 0
  ds_write_b128 v29, v[8:11]
  ds_write_b64 v29, v[8:9] offset:16
L_noinit:
  v_and_b32 v6, 3, v4
  v_lshrrev_b32 v7, 2, v4
  v_lshl_add_u32 v6, v6, 2, v7
  v_lshlrev_b32 v6, 8, v6
  v_lshl_add_u32 v2, v5, 4, v6
  v_mov_b32 v30, 1
  v_lshrrev_b32 v24, 2, v1
  v_lshlrev_b32 v24, 13, v24
  v_and_b32 v11, 3, v1
  v_lshl_add_u32 v24, v11, 4, v24
  v_and_b32 v25, 1, v1
  v_lshlrev_b32 v25, 10, v25
  v_lshl_add_u32 v25, v5, 4, v25
  s_lshl_b32 s59, s3, 8
  v_add_u32 v25, s59, v25
  s_and_b32 s55, s31, 7
  s_lshl_b32 s55, s55, 1
  s_lshr_b32 s59, s31, 3
  s_or_b32 s55, s55, s59
  s_lshl_b32 s61, s3, 20
  s_lshl_b32 s60, s41, 10
  s_add_u32 s61, s61, s60
  s_lshl_b32 s60, s55, 6
  s_add_u32 s61, s61, s60
  s_lshl_b32 s62, s3, 13
  s_waitcnt lgkmcnt(0)
  s_barrier
  s_cmp_eq_u32 s40, 0
  s_cselect_b32 s52, s10, s20
  s_cselect_b32 s53, s11, s21
  s_cselect_b32 s50, s4, s14
  s_cselect_b32 s51, s5, s15
  s_add_u32 s52, s52, s61
  s_addc_u32 s53, s53, 0
  s_lshl_b32 s59, s31, 2
  s_or_b32 s59, s59, s3
  s_cmp_lg_u32 s59, 0
  s_cbranch_scc1 L_nopool
  s_lshl_b32 s59, s30, 8
  s_add_u32 s59, s59, 1966080
  v_mov_b32 v26, s59
  s_mov_b64 exec, 1
  global_store_dword v26, v22, s[28:29] sc1
  s_mov_b64 exec, -1
L_nopool:
  s_add_u32 m0, s62, 0
  s_nop 0
  global_load_lds_dwordx4 v24, s[52:53] nt
  s_add_u32 m0, s62, 1024
  s_add_u32 s52, s52, 0x20000
  s_addc_u32 s53, s53, 0
  global_load_lds_dwordx4 v24, s[52:53] nt
  s_add_u32 m0, s62, 2048
  s_add_u32 s52, s52, 0x20000
  s_addc_u32 s53, s53, 0
  global_load_lds_dwordx4 v24, s[52:53] nt
  s_add_u32 m0, s62, 3072
  s_add_u32 s52, s52, 0x20000
  s_addc_u32 s53, s53, 0
  global_load_lds_dwordx4 v24, s[52:53] nt
  s_add_u32 m0, s62, 4096
  s_add_u32 s52, s52, 0x20000
  s_addc_u32 s53, s53, 0
  global_load_lds_dwordx4 v24, s[52:53] nt
  s_add_u32 m0, s62, 5120
  s_add_u32 s52, s52, 0x20000
  s_addc_u32 s53, s53, 0
  global_load_lds_dwordx4 v24, s[52:53] nt
  s_add_u32 m0, s62, 6144
  s_add_u32 s52, s52, 0x20000
  s_addc_u32 s53, s53, 0
  global_load_lds_dwordx4 v24, s[52:53] nt
  s_add_u32 m0, s62, 7168
  s_add_u32 s52, s52, 0x20000
  s_addc_u32 s53, s53, 0
  global_load_lds_dwordx4 v24, s[52:53] nt
  global_load_dwordx4 v[144:147], v25, s[50:51] offset:0
  global_load_dwordx4 v[148:151], v25, s[50:51] offset:64
  global_load_dwordx4 v[152:155], v25, s[50:51] offset:128
  global_load_dwordx4 v[156:159], v25, s[50:51] offset:192
  global_load_dword v31, v22, s[28:29] offset:0 sc1
  s_lshl_b32 s59, s30, 23
  s_add_u32 s32, s16, s59
  s_addc_u32 s33, s17, 0
  s_and_b32 s33, s33, 0xffff
  s_add_u32 s36, s18, s59
  s_addc_u32 s37, s19, 0
  s_and_b32 s37, s37, 0xffff
  s_mov_b32 s34, 0x800000
  s_mov_b32 s35, 0x20000
  s_mov_b32 s38, 0x800000
  s_mov_b32 s39, 0x20000
  s_lshl_b32 s44, s31, 16
  s_lshl_b32 s60, s3, 13
  s_add_u32 s44, s44, s60
  s_add_u32 s44, s44, 7340032
  s_add_u32 s45, s44, 4096
  buffer_load_dwordx4 v[80:83], v2, s[32:35], s44 offen offset:0 nt
  buffer_load_dwordx4 v[84:87], v2, s[32:35], s44 offen offset:64 nt
  buffer_load_dwordx4 v[88:91], v2, s[32:35], s44 offen offset:128 nt
  buffer_load_dwordx4 v[92:95], v2, s[32:35], s44 offen offset:192 nt
  buffer_load_dwordx4 v[96:99], v2, s[32:35], s45 offen offset:0 nt
  buffer_load_dwordx4 v[100:103], v2, s[32:35], s45 offen offset:64 nt
  buffer_load_dwordx4 v[104:107], v2, s[32:35], s45 offen offset:128 nt
  buffer_load_dwordx4 v[108:111], v2, s[32:35], s45 offen offset:192 nt
  buffer_load_dwordx4 v[112:115], v3, s[36:39], s44 offen offset:0 nt
  buffer_load_dwordx4 v[116:119], v3, s[36:39], s44 offen offset:1024 nt
  buffer_load_dwordx4 v[120:123], v3, s[36:39], s44 offen offset:2048 nt
  buffer_load_dwordx4 v[124:127], v3, s[36:39], s44 offen offset:3072 nt
  buffer_load_dwordx4 v[128:131], v3, s[36:39], s45 offen offset:0 nt
  buffer_load_dwordx4 v[132:135], v3, s[36:39], s45 offen offset:1024 nt
  buffer_load_dwordx4 v[136:139], v3, s[36:39], s45 offen offset:2048 nt
  buffer_load_dwordx4 v[140:143], v3, s[36:39], s45 offen offset:3072 nt
  s_add_u32 s44, s44, 0x8000
  s_add_u32 s45, s45, 0x8000
  s_mov_b32 s47, 0x05040100
  s_mov_b32 s48, 0x07060302
  s_mov_b32 s49, 0x3e0293ee
  s_lshl_b32 s56, s40, 4
  s_add_u32 s56, s56, s31
  s_and_b32 s57, s56, 7
  s_lshr_b32 s56, s56, 3
  s_lshl_b32 s58, s41, 2
  s_add_u32 s58, s58, s56
  s_lshl_b32 s67, s31, 19
  v_lshrrev_b32 v6, 2, v4
  v_lshl_add_u32 v6, v5, 3, v6
  v_lshlrev_b32 v6, 6, v6
  v_and_b32 v7, 3, v4
  v_lshl_add_u32 v6, v7, 3, v6
  v_add_u32 v6, s62, v6
  v_lshlrev_b32 v7, 7, v4
  v_lshl_add_u32 v7, v5, 4, v7
  s_lshl_b32 s59, s3, 8
  s_add_u32 s59, s59, 65536
  v_add_u32 v7, s59, v7
  s_waitcnt vmcnt(16)
  ds_read_b64_tr_b16 v[176:177], v6 offset:0
  ds_read_b64_tr_b16 v[178:179], v6 offset:256
  ds_read_b64_tr_b16 v[180:181], v6 offset:32
  ds_read_b64_tr_b16 v[182:183], v6 offset:288
  ds_read_b64_tr_b16 v[184:185], v6 offset:2048
  ds_read_b64_tr_b16 v[186:187], v6 offset:2304
  ds_read_b64_tr_b16 v[188:189], v6 offset:2080
  ds_read_b64_tr_b16 v[190:191], v6 offset:2336
  ds_read_b64_tr_b16 v[192:193], v6 offset:4096
  ds_read_b64_tr_b16 v[194:195], v6 offset:4352
  ds_read_b64_tr_b16 v[196:197], v6 offset:4128
  ds_read_b64_tr_b16 v[198:199], v6 offset:4384
  ds_read_b64_tr_b16 v[200:201], v6 offset:6144
  ds_read_b64_tr_b16 v[202:203], v6 offset:6400
  ds_read_b64_tr_b16 v[204:205], v6 offset:6176
  ds_read_b64_tr_b16 v[206:207], v6 offset:6432
  v_readfirstlane_b32 s43, v31
  s_waitcnt lgkmcnt(0)
  v_mfma_f32_16x16x32_bf16 v[8:11], v[176:179], v[144:147], 0
  v_mfma_f32_16x16x32_bf16 v[12:15], v[180:183], v[144:147], 0
  v_mfma_f32_16x16x32_bf16 v[8:11], v[184:187], v[148:151], v[8:11]
  v_mfma_f32_16x16x32_bf16 v[12:15], v[188:191], v[148:151], v[12:15]
  v_mfma_f32_16x16x32_bf16 v[8:11], v[192:195], v[152:155], v[8:11]
  v_mfma_f32_16x16x32_bf16 v[12:15], v[196:199], v[152:155], v[12:15]
  v_mfma_f32_16x16x32_bf16 v[8:11], v[200:203], v[156:159], v[8:11]
  v_mfma_f32_16x16x32_bf16 v[12:15], v[204:207], v[156:159], v[12:15]
  s_add_u32 s42, s43, 0x9e3779b9
  s_nop 5
  s_mov_b32 exec_lo, 0x00030003
  s_mov_b32 exec_hi, 0x00030003
  ds_write_b128 v7, v[8:11] offset:512
  ds_write_b128 v7, v[12:15] offset:576
  s_mov_b64 exec, 1
  ds_add_u32 v29, v30 offset:4
  s_mov_b64 exec, -1
  s_cmp_eq_u32 s3, 0
  s_cbranch_scc1 L_w0
  s_mov_b32 s66, 524288
L_pub:
  ds_read_b32 v27, v29 offset:16
  s_waitcnt lgkmcnt(0)
  v_readfirstlane_b32 s59, v27
  s_cmp_eq_u32 s59, 1
  s_cbranch_scc1 L_pub_ok
  s_sleep 1
  s_sub_u32 s66, s66, 1
  s_cbranch_scc0 L_pub
L_pub_ok:
  buffer_load_dwordx4 v[176:179], v2, s[32:35], s44 offen offset:0 nt
  buffer_load_dwordx4 v[180:183], v2, s[32:35], s44 offen offset:64 nt
  buffer_load_dwordx4 v[184:187], v2, s[32:35], s44 offen offset:128 nt
  buffer_load_dwordx4 v[188:191], v2, s[32:35], s44 offen offset:192 nt
  buffer_load_dwordx4 v[192:195], v2, s[32:35], s45 offen offset:0 nt
  buffer_load_dwordx4 v[196:199], v2, s[32:35], s45 offen offset:64 nt
  buffer_load_dwordx4 v[200:203], v2, s[32:35], s45 offen offset:128 nt
  buffer_load_dwordx4 v[204:207], v2, s[32:35], s45 offen offset:192 nt
  buffer_load_dwordx4 v[208:211], v3, s[36:39], s44 offen offset:0 nt
  buffer_load_dwordx4 v[212:215], v3, s[36:39], s44 offen offset:1024 nt
  buffer_load_dwordx4 v[216:219], v3, s[36:39], s44 offen offset:2048 nt
  buffer_load_dwordx4 v[220:223], v3, s[36:39], s44 offen offset:3072 nt
  buffer_load_dwordx4 v[224:227], v3, s[36:39], s45 offen offset:0 nt
  buffer_load_dwordx4 v[228:231], v3, s[36:39], s45 offen offset:1024 nt
  buffer_load_dwordx4 v[232:235], v3, s[36:39], s45 offen offset:2048 nt
  buffer_load_dwordx4 v[236:239], v3, s[36:39], s45 offen offset:3072 nt
  s_branch L_wo
L_w0:
  s_lshl_b32 s59, s40, 6
  s_lshl_b32 s60, s41, 2
  s_add_u32 s59, s59, s60
  s_lshr_b32 s60, s55, 2
  s_add_u32 s59, s59, s60
  s_lshl_b32 s59, s59, 9
  s_and_b32 s60, s55, 3
  s_lshl_b32 s60, s60, 7
  s_add_u32 s59, s59, s60
  s_add_u32 s59, s59, 4096
  v_bfe_u32 v6, v1, 4, 1
  v_lshlrev_b32 v8, 14, v6
  v_lshl_add_u32 v8, v4, 3, v8
  v_add_u32 v8, s59, v8
  v_lshlrev_b32 v7, 7, v6
  v_lshl_add_u32 v7, v4, 3, v7
  v_add_u32 v7, 65536, v7
  s_lshl_b32 s59, s40, 5
  s_lshl_b32 s60, s41, 2
  s_add_u32 s59, s59, s60
  s_lshl_b32 s59, s59, 9
  s_add_u32 s59, s59, 4096
  v_add_u32 v12, s59, v3
  v_add_u32 v13, 32768, v12
  s_mov_b32 s66, 524288
L_lq:
  ds_read_b32 v27, v29 offset:4
  s_waitcnt lgkmcnt(0)
  v_readfirstlane_b32 s59, v27
  s_cmp_eq_u32 s59, 4
  s_cbranch_scc1 L_lq_ok
  s_sub_u32 s66, s66, 1
  s_cbranch_scc0 L_lq
L_lq_ok:
  ds_read_b64 v[144:145], v7 offset:512
  ds_read_b64 v[146:147], v7 offset:768
  ds_read_b64 v[148:149], v7 offset:1024
  ds_read_b64 v[150:151], v7 offset:1280
  s_waitcnt lgkmcnt(0)
  v_add_f32 v144, v144, v146
  v_add_f32 v148, v148, v150
  v_add_f32 v145, v145, v147
  v_add_f32 v149, v149, v151
  v_add_f32 v144, v144, v148
  v_add_f32 v145, v145, v149
  v_cvt_pk_bf16_f32 v10, v144, v145
  v_mov_b32 v11, s42
  s_mov_b32 exec_hi, 0
  global_store_dwordx2 v8, v[10:11], s[28:29] sc1
  s_mov_b32 exec_hi, -1
  ds_write_b32 v29, v30 offset:16
  buffer_load_dwordx4 v[176:179], v2, s[32:35], s44 offen offset:0 nt
  buffer_load_dwordx4 v[180:183], v2, s[32:35], s44 offen offset:64 nt
  buffer_load_dwordx4 v[184:187], v2, s[32:35], s44 offen offset:128 nt
  buffer_load_dwordx4 v[188:191], v2, s[32:35], s44 offen offset:192 nt
  buffer_load_dwordx4 v[192:195], v2, s[32:35], s45 offen offset:0 nt
  buffer_load_dwordx4 v[196:199], v2, s[32:35], s45 offen offset:64 nt
  buffer_load_dwordx4 v[200:203], v2, s[32:35], s45 offen offset:128 nt
  buffer_load_dwordx4 v[204:207], v2, s[32:35], s45 offen offset:192 nt
  buffer_load_dwordx4 v[208:211], v3, s[36:39], s44 offen offset:0 nt
  buffer_load_dwordx4 v[212:215], v3, s[36:39], s44 offen offset:1024 nt
  buffer_load_dwordx4 v[216:219], v3, s[36:39], s44 offen offset:2048 nt
  buffer_load_dwordx4 v[220:223], v3, s[36:39], s44 offen offset:3072 nt
  buffer_load_dwordx4 v[224:227], v3, s[36:39], s45 offen offset:0 nt
  buffer_load_dwordx4 v[228:231], v3, s[36:39], s45 offen offset:1024 nt
  buffer_load_dwordx4 v[232:235], v3, s[36:39], s45 offen offset:2048 nt
  buffer_load_dwordx4 v[236:239], v3, s[36:39], s45 offen offset:3072 nt
  s_waitcnt vmcnt(16)
  s_mov_b32 s66, 524288
L_qpoll:
  global_load_dwordx4 v[144:147], v12, s[28:29] sc1
  global_load_dwordx4 v[148:151], v12, s[28:29] offset:1024 sc1
  global_load_dwordx4 v[152:155], v13, s[28:29] sc1
  global_load_dwordx4 v[156:159], v13, s[28:29] offset:1024 sc1
  s_waitcnt vmcnt(0)
  v_cmp_eq_u32 vcc, s42, v145
  v_cmp_eq_u32 s[64:65], s42, v147
  s_and_b64 vcc, vcc, s[64:65]
  v_cmp_eq_u32 s[64:65], s42, v149
  s_and_b64 vcc, vcc, s[64:65]
  v_cmp_eq_u32 s[64:65], s42, v151
  s_and_b64 vcc, vcc, s[64:65]
  v_cmp_eq_u32 s[64:65], s42, v153
  s_and_b64 vcc, vcc, s[64:65]
  v_cmp_eq_u32 s[64:65], s42, v155
  s_and_b64 vcc, vcc, s[64:65]
  v_cmp_eq_u32 s[64:65], s42, v157
  s_and_b64 vcc, vcc, s[64:65]
  v_cmp_eq_u32 s[64:65], s42, v159
  s_and_b64 vcc, vcc, s[64:65]
  s_cmp_eq_u64 vcc, -1
  s_cbranch_scc1 L_qok
  s_sub_u32 s66, s66, 1
  s_cbranch_scc1 L_qok
  s_branch L_qpoll
L_qok:
  v_lshlrev_b32 v6, 3, v1
  v_add_u32 v7, 68096, v6
  ds_write2_b32 v7, v144, v146 offset0:0 offset1:1
  v_add_u32 v7, 68608, v6
  ds_write2_b32 v7, v148, v150 offset0:0 offset1:1
  v_add_u32 v7, 69120, v6
  ds_write2_b32 v7, v152, v154 offset0:0 offset1:1
  v_add_u32 v7, 69632, v6
  ds_write2_b32 v7, v156, v158 offset0:0 offset1:1
  ds_write_b32 v29, v30 offset:8
L_wo:
  v_lshrrev_b32 v10, 4, v1
  v_lshlrev_b32 v10, 10, v10
  v_lshl_add_u32 v10, v4, 4, v10
  s_lshl_b32 s59, s58, 17
  s_lshl_b32 s60, s3, 15
  s_add_u32 s59, s59, s60
  s_lshr_b32 s60, s57, 2
  s_lshl_b32 s60, s60, 12
  s_add_u32 s59, s59, s60
  s_and_b32 s60, s57, 3
  s_lshl_b32 s60, s60, 8
  s_add_u32 s59, s59, s60
  s_lshl_b32 s60, s3, 12
  s_add_u32 s52, s12, s59
  s_addc_u32 s53, s13, 0
  s_add_u32 m0, s60, 32768
  s_nop 0
  global_load_lds_dwordx4 v10, s[52:53] nt
  s_add_u32 m0, s60, 33792
  s_add_u32 s52, s52, 0x2000
  s_addc_u32 s53, s53, 0
  global_load_lds_dwordx4 v10, s[52:53] nt
  s_add_u32 m0, s60, 34816
  s_add_u32 s52, s52, 0x2000
  s_addc_u32 s53, s53, 0
  global_load_lds_dwordx4 v10, s[52:53] nt
  s_add_u32 m0, s60, 35840
  s_add_u32 s52, s52, 0x2000
  s_addc_u32 s53, s53, 0
  global_load_lds_dwordx4 v10, s[52:53] nt
  s_add_u32 s52, s22, s59
  s_addc_u32 s53, s23, 0
  s_add_u32 m0, s60, 49152
  s_nop 0
  global_load_lds_dwordx4 v10, s[52:53] nt
  s_add_u32 m0, s60, 50176
  s_add_u32 s52, s52, 0x2000
  s_addc_u32 s53, s53, 0
  global_load_lds_dwordx4 v10, s[52:53] nt
  s_add_u32 m0, s60, 51200
  s_add_u32 s52, s52, 0x2000
  s_addc_u32 s53, s53, 0
  global_load_lds_dwordx4 v10, s[52:53] nt
  s_add_u32 m0, s60, 52224
  s_add_u32 s52, s52, 0x2000
  s_addc_u32 s53, s53, 0
  global_load_lds_dwordx4 v10, s[52:53] nt
  s_lshl_b32 s59, s30, 23
  s_add_u32 s32, s6, s59
  s_addc_u32 s33, s7, 0
  s_and_b32 s33, s33, 0xffff
  s_add_u32 s36, s8, s59
  s_addc_u32 s37, s9, 0
  s_and_b32 s37, s37, 0xffff
  s_mov_b32 s34, 0x800000
  s_mov_b32 s35, 0x20000
  s_mov_b32 s38, 0x800000
  s_mov_b32 s39, 0x20000
  s_mov_b32 s66, 524288
L_qflag:
  ds_read_b32 v27, v29 offset:8
  s_waitcnt lgkmcnt(0)
  v_readfirstlane_b32 s59, v27
  s_cmp_eq_u32 s59, 1
  s_cbranch_scc1 L_qflag_ok
  s_sleep 1
  s_sub_u32 s66, s66, 1
  s_cbranch_scc0 L_qflag
L_qflag_ok:
  v_and_b32 v6, 3, v4
  v_lshlrev_b32 v6, 8, v6
  v_lshl_add_u32 v31, v5, 4, v6
  v_add_u32 v31, 65536, v31
  ds_read_b128 v[64:67], v31 offset:3584
  ds_read_b128 v[68:71], v31 offset:3648
  ds_read_b128 v[72:75], v31 offset:3712
  ds_read_b128 v[76:79], v31 offset:3776
  v_mov_b32 v32, 0
  v_mov_b32 v33, 0
  v_mov_b32 v34, 0
  v_mov_b32 v35, 0
  v_mov_b32 v36, 0
  v_mov_b32 v37, 0
  v_mov_b32 v38, 0
  v_mov_b32 v39, 0
  v_mov_b32 v40, 0
  v_mov_b32 v41, 0
  v_mov_b32 v42, 0
  v_mov_b32 v43, 0
  v_mov_b32 v44, 0
  v_mov_b32 v45, 0
  v_mov_b32 v46, 0
  v_mov_b32 v47, 0
  v_mov_b32 v48, 0
  v_mov_b32 v49, 0
  v_mov_b32 v50, 0
  v_mov_b32 v51, 0
  v_mov_b32 v52, 0
  v_mov_b32 v53, 0
  v_mov_b32 v54, 0
  v_mov_b32 v55, 0
  v_mov_b32 v56, 0
  v_mov_b32 v57, 0
  v_mov_b32 v58, 0
  v_mov_b32 v59, 0
  v_mov_b32 v60, 0
  v_mov_b32 v61, 0
  v_mov_b32 v62, 0
  v_mov_b32 v63, 0
  v_mov_b32 v20, 0xf149f2ca
  v_mov_b32 v21, 0
  s_mov_b32 s54, 1
  s_mov_b32 s69, 0
  s_mov_b32 s46, 0
  v_mov_b32 v7, 0
  s_lshl_b32 s59, s30, 8
  s_add_u32 s50, s28, s59
  s_addc_u32 s51, s29, 0
  s_add_u32 s50, s50, 1966080
  s_addc_u32 s51, s51, 0
  s_waitcnt lgkmcnt(0)
L_t0:
  s_cmp_lg_u32 s46, 0
  s_cbranch_scc1 L_pool68
  s_mov_b64 exec, 1
  ds_add_rtn_u32 v26, v29, v30
  s_mov_b64 exec, -1
  s_waitcnt vmcnt(12)
  v_mfma_f32_16x16x32_bf16 v[8:11], v[80:83], v[64:67], 0
  v_mfma_f32_16x16x32_bf16 v[8:11], v[84:87], v[68:71], v[8:11]
  v_mfma_f32_16x16x32_bf16 v[8:11], v[88:91], v[72:75], v[8:11]
  v_mfma_f32_16x16x32_bf16 v[8:11], v[92:95], v[76:79], v[8:11]
  s_waitcnt lgkmcnt(0)
  v_readfirstlane_b32 s68, v26
  s_cmp_ge_u32 s68, 54
  s_cbranch_scc1 L_sw68
L_swret68:
  s_lshl_b32 s44, s68, 13
  s_add_u32 s44, s44, s67
  s_add_u32 s45, s44, 4096
  s_cmp_lt_u32 s68, 64
L_join68:
  s_cselect_b32 s34, 0x800000, 0
  s_cselect_b32 s38, 0x800000, 0
  buffer_load_dwordx4 v[80:83], v2, s[32:35], s44 offen offset:0 nt
  buffer_load_dwordx4 v[84:87], v2, s[32:35], s44 offen offset:64 nt
  buffer_load_dwordx4 v[88:91], v2, s[32:35], s44 offen offset:128 nt
  buffer_load_dwordx4 v[92:95], v2, s[32:35], s44 offen offset:192 nt
  s_waitcnt vmcnt(12)
  v_mfma_f32_16x16x32_bf16 v[12:15], v[96:99], v[64:67], 0
  v_mfma_f32_16x16x32_bf16 v[12:15], v[100:103], v[68:71], v[12:15]
  v_mfma_f32_16x16x32_bf16 v[12:15], v[104:107], v[72:75], v[12:15]
  v_mfma_f32_16x16x32_bf16 v[12:15], v[108:111], v[76:79], v[12:15]
  buffer_load_dwordx4 v[96:99], v2, s[32:35], s45 offen offset:0 nt
  buffer_load_dwordx4 v[100:103], v2, s[32:35], s45 offen offset:64 nt
  buffer_load_dwordx4 v[104:107], v2, s[32:35], s45 offen offset:128 nt
  buffer_load_dwordx4 v[108:111], v2, s[32:35], s45 offen offset:192 nt
  v_max3_f32 v22, v8, v9, v10
  v_max_f32 v22, v22, v11
  s_nop 1
  v_max3_f32 v22, v22, v12, v13
  v_max3_f32 v22, v22, v14, v15
  v_mov_b32 v23, v22
  s_nop 1
  v_permlane32_swap_b32 v23, v22
  v_max_f32 v22, v22, v23
  v_mov_b32 v23, v22
  s_nop 1
  v_permlane16_swap_b32 v23, v22
  v_max_f32 v22, v22, v23
  v_mul_f32 v22, s49, v22
  v_max_f32 v23, v20, v22
  v_sub_f32 v24, v20, v23
  v_exp_f32 v28, v24
  v_mov_b32 v20, v23
  v_fma_f32 v8, v8, s49, -v23
  v_fma_f32 v9, v9, s49, -v23
  v_fma_f32 v10, v10, s49, -v23
  v_fma_f32 v11, v11, s49, -v23
  v_fma_f32 v12, v12, s49, -v23
  v_fma_f32 v13, v13, s49, -v23
  v_fma_f32 v14, v14, s49, -v23
  v_fma_f32 v15, v15, s49, -v23
  v_exp_f32 v8, v8
  v_exp_f32 v9, v9
  v_exp_f32 v10, v10
  v_exp_f32 v11, v11
  v_exp_f32 v12, v12
  v_exp_f32 v13, v13
  v_exp_f32 v14, v14
  v_exp_f32 v15, v15
  v_mul_f32 v21, v21, v28
  v_pk_mul_f32 v[32:33], v[32:33], v[28:29] op_sel_hi:[1,0]
  v_pk_mul_f32 v[34:35], v[34:35], v[28:29] op_sel_hi:[1,0]
  v_pk_mul_f32 v[36:37], v[36:37], v[28:29] op_sel_hi:[1,0]
  v_pk_mul_f32 v[38:39], v[38:39], v[28:29] op_sel_hi:[1,0]
  v_pk_mul_f32 v[40:41], v[40:41], v[28:29] op_sel_hi:[1,0]
  v_pk_mul_f32 v[42:43], v[42:43], v[28:29] op_sel_hi:[1,0]
  v_pk_mul_f32 v[44:45], v[44:45], v[28:29] op_sel_hi:[1,0]
  v_pk_mul_f32 v[46:47], v[46:47], v[28:29] op_sel_hi:[1,0]
  v_pk_mul_f32 v[48:49], v[48:49], v[28:29] op_sel_hi:[1,0]
  v_pk_mul_f32 v[50:51], v[50:51], v[28:29] op_sel_hi:[1,0]
  v_pk_mul_f32 v[52:53], v[52:53], v[28:29] op_sel_hi:[1,0]
  v_pk_mul_f32 v[54:55], v[54:55], v[28:29] op_sel_hi:[1,0]
  v_pk_mul_f32 v[56:57], v[56:57], v[28:29] op_sel_hi:[1,0]
  v_pk_mul_f32 v[58:59], v[58:59], v[28:29] op_sel_hi:[1,0]
  v_pk_mul_f32 v[60:61], v[60:61], v[28:29] op_sel_hi:[1,0]
  v_pk_mul_f32 v[62:63], v[62:63], v[28:29] op_sel_hi:[1,0]
  v_add_f32 v24, v8, v9
  v_add_f32 v25, v10, v11
  v_add_f32 v26, v12, v13
  v_add_f32 v27, v14, v15
  v_cvt_pk_bf16_f32 v16, v8, v9
  v_cvt_pk_bf16_f32 v17, v10, v11
  v_cvt_pk_bf16_f32 v18, v12, v13
  v_cvt_pk_bf16_f32 v19, v14, v15
  v_add_f32 v24, v24, v25
  v_add_f32 v26, v26, v27
  v_add_f32 v21, v21, v24
  v_add_f32 v21, v21, v26
  s_waitcnt vmcnt(12)
  v_perm_b32 v144, v116, v112, s47
  v_perm_b32 v145, v124, v120, s47
  v_perm_b32 v148, v116, v112, s48
  v_perm_b32 v149, v124, v120, s48
  v_perm_b32 v152, v117, v113, s47
  v_perm_b32 v153, v125, v121, s47
  v_perm_b32 v156, v117, v113, s48
  v_perm_b32 v157, v125, v121, s48
  v_perm_b32 v160, v118, v114, s47
  v_perm_b32 v161, v126, v122, s47
  v_perm_b32 v164, v118, v114, s48
  v_perm_b32 v165, v126, v122, s48
  v_perm_b32 v168, v119, v115, s47
  v_perm_b32 v169, v127, v123, s47
  v_perm_b32 v172, v119, v115, s48
  v_perm_b32 v173, v127, v123, s48
  buffer_load_dwordx4 v[112:115], v3, s[36:39], s44 offen offset:0 nt
  buffer_load_dwordx4 v[116:119], v3, s[36:39], s44 offen offset:1024 nt
  buffer_load_dwordx4 v[120:123], v3, s[36:39], s44 offen offset:2048 nt
  buffer_load_dwordx4 v[124:127], v3, s[36:39], s44 offen offset:3072 nt
  s_waitcnt vmcnt(12)
  v_perm_b32 v146, v132, v128, s47
  v_perm_b32 v147, v140, v136, s47
  v_perm_b32 v150, v132, v128, s48
  v_perm_b32 v151, v140, v136, s48
  v_perm_b32 v154, v133, v129, s47
  v_perm_b32 v155, v141, v137, s47
  v_perm_b32 v158, v133, v129, s48
  v_perm_b32 v159, v141, v137, s48
  v_perm_b32 v162, v134, v130, s47
  v_perm_b32 v163, v142, v138, s47
  v_perm_b32 v166, v134, v130, s48
  v_perm_b32 v167, v142, v138, s48
  v_perm_b32 v170, v135, v131, s47
  v_perm_b32 v171, v143, v139, s47
  v_perm_b32 v174, v135, v131, s48
  v_perm_b32 v175, v143, v139, s48
  buffer_load_dwordx4 v[128:131], v3, s[36:39], s45 offen offset:0 nt
  buffer_load_dwordx4 v[132:135], v3, s[36:39], s45 offen offset:1024 nt
  buffer_load_dwordx4 v[136:139], v3, s[36:39], s45 offen offset:2048 nt
  buffer_load_dwordx4 v[140:143], v3, s[36:39], s45 offen offset:3072 nt
  v_mfma_f32_16x16x32_bf16 v[32:35], v[144:147], v[16:19], v[32:35]
  v_mfma_f32_16x16x32_bf16 v[36:39], v[148:151], v[16:19], v[36:39]
  v_mfma_f32_16x16x32_bf16 v[40:43], v[152:155], v[16:19], v[40:43]
  v_mfma_f32_16x16x32_bf16 v[44:47], v[156:159], v[16:19], v[44:47]
  v_mfma_f32_16x16x32_bf16 v[48:51], v[160:163], v[16:19], v[48:51]
  v_mfma_f32_16x16x32_bf16 v[52:55], v[164:167], v[16:19], v[52:55]
  v_mfma_f32_16x16x32_bf16 v[56:59], v[168:171], v[16:19], v[56:59]
  v_mfma_f32_16x16x32_bf16 v[60:63], v[172:175], v[16:19], v[60:63]
  s_cmp_eq_u32 s54, 1
  s_cbranch_scc1 L_t1
  s_cmp_lt_u32 s68, 64
  s_cbranch_scc1 L_t0
  s_branch L_flush
L_t1:
  v_mfma_f32_16x16x32_bf16 v[8:11], v[176:179], v[64:67], 0
  v_mfma_f32_16x16x32_bf16 v[8:11], v[180:183], v[68:71], v[8:11]
  v_mfma_f32_16x16x32_bf16 v[8:11], v[184:187], v[72:75], v[8:11]
  v_mfma_f32_16x16x32_bf16 v[8:11], v[188:191], v[76:79], v[8:11]
  v_mfma_f32_16x16x32_bf16 v[12:15], v[192:195], v[64:67], 0
  v_mfma_f32_16x16x32_bf16 v[12:15], v[196:199], v[68:71], v[12:15]
  v_mfma_f32_16x16x32_bf16 v[12:15], v[200:203], v[72:75], v[12:15]
  v_mfma_f32_16x16x32_bf16 v[12:15], v[204:207], v[76:79], v[12:15]
  s_nop 3
  v_max3_f32 v22, v8, v9, v10
  v_max_f32 v22, v22, v11
  s_nop 1
  v_max3_f32 v22, v22, v12, v13
  v_max3_f32 v22, v22, v14, v15
  v_mov_b32 v23, v22
  s_nop 1
  v_permlane32_swap_b32 v23, v22
  v_max_f32 v22, v22, v23
  v_mov_b32 v23, v22
  s_nop 1
  v_permlane16_swap_b32 v23, v22
  v_max_f32 v22, v22, v23
  v_mul_f32 v22, s49, v22
  v_max_f32 v23, v20, v22
  v_sub_f32 v24, v20, v23
  v_exp_f32 v28, v24
  v_mov_b32 v20, v23
  v_fma_f32 v8, v8, s49, -v23
  v_fma_f32 v9, v9, s49, -v23
  v_fma_f32 v10, v10, s49, -v23
  v_fma_f32 v11, v11, s49, -v23
  v_fma_f32 v12, v12, s49, -v23
  v_fma_f32 v13, v13, s49, -v23
  v_fma_f32 v14, v14, s49, -v23
  v_fma_f32 v15, v15, s49, -v23
  v_exp_f32 v8, v8
  v_exp_f32 v9, v9
  v_exp_f32 v10, v10
  v_exp_f32 v11, v11
  v_exp_f32 v12, v12
  v_exp_f32 v13, v13
  v_exp_f32 v14, v14
  v_exp_f32 v15, v15
  v_mul_f32 v21, v21, v28
  v_pk_mul_f32 v[32:33], v[32:33], v[28:29] op_sel_hi:[1,0]
  v_pk_mul_f32 v[34:35], v[34:35], v[28:29] op_sel_hi:[1,0]
  v_pk_mul_f32 v[36:37], v[36:37], v[28:29] op_sel_hi:[1,0]
  v_pk_mul_f32 v[38:39], v[38:39], v[28:29] op_sel_hi:[1,0]
  v_pk_mul_f32 v[40:41], v[40:41], v[28:29] op_sel_hi:[1,0]
  v_pk_mul_f32 v[42:43], v[42:43], v[28:29] op_sel_hi:[1,0]
  v_pk_mul_f32 v[44:45], v[44:45], v[28:29] op_sel_hi:[1,0]
  v_pk_mul_f32 v[46:47], v[46:47], v[28:29] op_sel_hi:[1,0]
  v_pk_mul_f32 v[48:49], v[48:49], v[28:29] op_sel_hi:[1,0]
  v_pk_mul_f32 v[50:51], v[50:51], v[28:29] op_sel_hi:[1,0]
  v_pk_mul_f32 v[52:53], v[52:53], v[28:29] op_sel_hi:[1,0]
  v_pk_mul_f32 v[54:55], v[54:55], v[28:29] op_sel_hi:[1,0]
  v_pk_mul_f32 v[56:57], v[56:57], v[28:29] op_sel_hi:[1,0]
  v_pk_mul_f32 v[58:59], v[58:59], v[28:29] op_sel_hi:[1,0]
  v_pk_mul_f32 v[60:61], v[60:61], v[28:29] op_sel_hi:[1,0]
  v_pk_mul_f32 v[62:63], v[62:63], v[28:29] op_sel_hi:[1,0]
  v_add_f32 v24, v8, v9
  v_add_f32 v25, v10, v11
  v_add_f32 v26, v12, v13
  v_add_f32 v27, v14, v15
  v_cvt_pk_bf16_f32 v16, v8, v9
  v_cvt_pk_bf16_f32 v17, v10, v11
  v_cvt_pk_bf16_f32 v18, v12, v13
  v_cvt_pk_bf16_f32 v19, v14, v15
  v_add_f32 v24, v24, v25
  v_add_f32 v26, v26, v27
  v_add_f32 v21, v21, v24
  v_add_f32 v21, v21, v26
  v_perm_b32 v144, v212, v208, s47
  v_perm_b32 v145, v220, v216, s47
  v_perm_b32 v148, v212, v208, s48
  v_perm_b32 v149, v220, v216, s48
  v_perm_b32 v152, v213, v209, s47
  v_perm_b32 v153, v221, v217, s47
  v_perm_b32 v156, v213, v209, s48
  v_perm_b32 v157, v221, v217, s48
  v_perm_b32 v160, v214, v210, s47
  v_perm_b32 v161, v222, v218, s47
  v_perm_b32 v164, v214, v210, s48
  v_perm_b32 v165, v222, v218, s48
  v_perm_b32 v168, v215, v211, s47
  v_perm_b32 v169, v223, v219, s47
  v_perm_b32 v172, v215, v211, s48
  v_perm_b32 v173, v223, v219, s48
  v_perm_b32 v146, v228, v224, s47
  v_perm_b32 v147, v236, v232, s47
  v_perm_b32 v150, v228, v224, s48
  v_perm_b32 v151, v236, v232, s48
  v_perm_b32 v154, v229, v225, s47
  v_perm_b32 v155, v237, v233, s47
  v_perm_b32 v158, v229, v225, s48
  v_perm_b32 v159, v237, v233, s48
  v_perm_b32 v162, v230, v226, s47
  v_perm_b32 v163, v238, v234, s47
  v_perm_b32 v166, v230, v226, s48
  v_perm_b32 v167, v238, v234, s48
  v_perm_b32 v170, v231, v227, s47
  v_perm_b32 v171, v239, v235, s47
  v_perm_b32 v174, v231, v227, s48
  v_perm_b32 v175, v239, v235, s48
  s_nop 1
  v_mfma_f32_16x16x32_bf16 v[32:35], v[144:147], v[16:19], v[32:35]
  v_mfma_f32_16x16x32_bf16 v[36:39], v[148:151], v[16:19], v[36:39]
  v_mfma_f32_16x16x32_bf16 v[40:43], v[152:155], v[16:19], v[40:43]
  v_mfma_f32_16x16x32_bf16 v[44:47], v[156:159], v[16:19], v[44:47]
  v_mfma_f32_16x16x32_bf16 v[48:51], v[160:163], v[16:19], v[48:51]
  v_mfma_f32_16x16x32_bf16 v[52:55], v[164:167], v[16:19], v[52:55]
  v_mfma_f32_16x16x32_bf16 v[56:59], v[168:171], v[16:19], v[56:59]
  v_mfma_f32_16x16x32_bf16 v[60:63], v[172:175], v[16:19], v[60:63]
L_flush:
  v_mov_b32 v23, v21
  s_nop 1
  v_permlane32_swap_b32 v23, v21
  v_add_f32 v21, v21, v23
  v_mov_b32 v23, v21
  s_nop 1
  v_permlane16_swap_b32 v23, v21
  v_add_f32 v21, v21, v23
  s_lshl_b32 s59, s54, 2
  s_add_u32 s59, s59, s3
  s_lshl_b32 s59, s59, 11
  v_lshlrev_b32 v6, 9, v4
  v_lshl_add_u32 v6, v5, 4, v6
  v_add_u32 v6, s59, v6
  s_lshl_b32 s59, s54, 7
  s_lshl_b32 s60, s3, 3
  s_add_u32 s59, s59, s60
  s_add_u32 s59, s59, 65536
  v_lshlrev_b32 v7, 5, v4
  v_add_u32 v7, s59, v7
  v_mov_b32 v22, v20
  v_mov_b32 v23, v21
  s_mov_b32 exec_lo, 0x000f000f
  s_mov_b32 exec_hi, 0x000f000f
  ds_write_b128 v6, v[32:35] offset:0
  ds_write_b128 v6, v[36:39] offset:64
  ds_write_b128 v6, v[40:43] offset:128
  ds_write_b128 v6, v[44:47] offset:192
  ds_write_b128 v6, v[48:51] offset:256
  ds_write_b128 v6, v[52:55] offset:320
  ds_write_b128 v6, v[56:59] offset:384
  ds_write_b128 v6, v[60:63] offset:448
  s_mov_b64 exec, 15
  ds_write_b64 v7, v[22:23] offset:0
  s_mov_b64 exec, -1
  s_cmp_eq_u32 s54, 0
  s_cbranch_scc1 L_tail
  ds_read_b128 v[64:67], v31 offset:2560
  ds_read_b128 v[68:71], v31 offset:2624
  ds_read_b128 v[72:75], v31 offset:2688
  ds_read_b128 v[76:79], v31 offset:2752
  v_lshrrev_b32 v13, 5, v1
  v_and_b32 v14, 31, v1
  v_lshlrev_b32 v240, 13, v13
  v_lshl_add_u32 v240, v14, 4, v240
  s_lshl_b32 s61, s3, 9
  v_add_u32 v240, s61, v240
  v_lshlrev_b32 v241, 7, v13
  s_lshl_b32 s61, s3, 5
  s_add_u32 s61, s61, 65536
  v_add_u32 v241, s61, v241
  s_lshl_b32 s61, s30, 2
  s_add_u32 s61, s61, s3
  s_lshl_b32 s61, s61, 4
  s_add_u32 s61, s61, s31
  s_lshl_b32 s62, s61, 9
  s_add_u32 s62, s62, 131072
  v_lshlrev_b32 v242, 19, v13
  v_lshl_add_u32 v242, v14, 4, v242
  v_add_u32 v242, s62, v242
  s_lshl_b32 s62, s61, 7
  s_add_u32 s62, s62, 1179648
  v_lshlrev_b32 v243, 17, v13
  v_and_b32 v15, 7, v1
  v_lshl_add_u32 v243, v15, 4, v243
  v_add_u32 v243, s62, v243
  s_lshr_b32 s59, s3, 1
  s_and_b32 s60, s3, 1
  s_lshl_b32 s61, s59, 4
  s_lshl_b32 s62, s60, 3
  s_add_u32 s61, s61, s62
  s_add_u32 s61, s61, s41
  s_lshl_b32 s61, s61, 2
  s_add_u32 s61, s61, s56
  s_lshl_b32 s62, s61, 11
  s_add_u32 s62, s62, 1179648
  v_and_b32 v244, 3, v1
  v_lshl_add_u32 v244, v244, 2, v5
  v_lshlrev_b32 v244, 7, v244
  v_add_u32 v244, s62, v244
  s_lshl_b32 s62, s61, 13
  s_lshr_b32 s60, s57, 2
  s_lshl_b32 s60, s60, 8
  s_add_u32 s62, s62, s60
  s_add_u32 s62, s62, 131072
  v_lshlrev_b32 v245, 9, v5
  v_lshl_add_u32 v245, v4, 4, v245
  v_add_u32 v245, s62, v245
  v_add_u32 v246, 4096, v245
  v_and_b32 v15, 3, v4
  v_lshlrev_b32 v247, 5, v15
  v_lshrrev_b32 v15, 2, v4
  v_lshl_add_u32 v247, v15, 1, v247
  s_lshl_b32 s61, s3, 7
  s_add_u32 s61, s61, 65536
  v_add_u32 v247, s61, v247
  v_lshrrev_b32 v248, 2, v4
  v_lshl_add_u32 v248, v5, 3, v248
  v_lshlrev_b32 v248, 8, v248
  v_and_b32 v13, 3, v4
  v_lshl_add_u32 v248, v13, 3, v248
  s_lshl_b32 s62, s3, 6
  s_add_u32 s62, s62, 32768
  v_add_u32 v248, s62, v248
  v_and_b32 v249, 1, v4
  v_lshlrev_b32 v249, 7, v249
  v_lshl_add_u32 v249, v5, 4, v249
  v_add_u32 v249, 65536, v249
  s_and_b32 s61, s57, 3
  s_lshl_b32 s61, s61, 3
  s_lshl_b32 s62, s3, 1
  s_add_u32 s61, s61, s62
  s_lshl_b32 s61, s61, 6
  s_lshl_b32 s62, s58, 1
  s_add_u32 s61, s61, s62
  s_lshr_b32 s62, s57, 2
  s_add_u32 s61, s61, s62
  s_lshl_b32 s61, s61, 7
  s_add_u32 s63, s61, 1441792
  v_and_b32 v250, 1, v4
  v_lshlrev_b32 v250, 6, v250
  v_lshl_add_u32 v250, v5, 4, v250
  v_add_u32 v250, s63, v250
  v_add_u32 v253, 0x2000, v250
  v_add_u32 v254, 0x40000, v250
  v_add_u32 v255, 0x42000, v250
  s_lshl_b32 s59, s2, 13
  s_add_u32 s59, s59, 1441792
  v_add_u32 v251, s59, v3
  v_bfe_u32 v252, v1, 2, 1
  v_lshlrev_b32 v252, 10, v252
  v_and_b32 v13, 3, v1
  v_lshl_add_u32 v252, v13, 2, v252
  s_lshl_b32 s59, s2, 4
  v_add_u32 v252, s59, v252
  v_lshlrev_b32 v252, 1, v252
  v_mov_b32 v32, 0
  v_mov_b32 v33, 0
  v_mov_b32 v34, 0
  v_mov_b32 v35, 0
  v_mov_b32 v36, 0
  v_mov_b32 v37, 0
  v_mov_b32 v38, 0
  v_mov_b32 v39, 0
  v_mov_b32 v40, 0
  v_mov_b32 v41, 0
  v_mov_b32 v42, 0
  v_mov_b32 v43, 0
  v_mov_b32 v44, 0
  v_mov_b32 v45, 0
  v_mov_b32 v46, 0
  v_mov_b32 v47, 0
  v_mov_b32 v48, 0
  v_mov_b32 v49, 0
  v_mov_b32 v50, 0
  v_mov_b32 v51, 0
  v_mov_b32 v52, 0
  v_mov_b32 v53, 0
  v_mov_b32 v54, 0
  v_mov_b32 v55, 0
  v_mov_b32 v56, 0
  v_mov_b32 v57, 0
  v_mov_b32 v58, 0
  v_mov_b32 v59, 0
  v_mov_b32 v60, 0
  v_mov_b32 v61, 0
  v_mov_b32 v62, 0
  v_mov_b32 v63, 0
  v_mov_b32 v20, 0xf149f2ca
  v_mov_b32 v21, 0
  s_mov_b32 s54, 0
  s_waitcnt lgkmcnt(0)
  s_cmp_lt_u32 s68, 64
  s_cbranch_scc1 L_t0
  s_branch L_flush
L_sw68:
  s_mov_b32 s46, 1
  v_mov_b32 v7, 0
  s_mov_b64 exec, 1
  global_atomic_add v6, v7, v30, s[50:51] sc0 sc1
  s_mov_b64 exec, -1
  s_branch L_swret68
L_pool68:
  s_waitcnt vmcnt(12)
  v_readfirstlane_b32 s59, v6
  v_mfma_f32_16x16x32_bf16 v[8:11], v[80:83], v[64:67], 0
  v_mfma_f32_16x16x32_bf16 v[8:11], v[84:87], v[68:71], v[8:11]
  v_mfma_f32_16x16x32_bf16 v[8:11], v[88:91], v[72:75], v[8:11]
  v_mfma_f32_16x16x32_bf16 v[8:11], v[92:95], v[76:79], v[8:11]
  s_and_b32 s44, s59, 15
  s_lshl_b32 s44, s44, 19
  s_lshr_b32 s60, s59, 4
  s_add_u32 s60, s60, 58
  s_lshl_b32 s60, s60, 13
  s_add_u32 s44, s44, s60
  s_add_u32 s45, s44, 4096
  s_cmp_lt_u32 s59, 96
  s_cselect_b32 s68, 0, 64
  s_cbranch_scc0 L_join68
  s_mov_b64 exec, 1
  global_atomic_add v6, v7, v30, s[50:51] sc0 sc1
  s_mov_b64 exec, -1
  s_branch L_join68
L_tail:
  v_mov_b32 v26, 0xfffff000
  s_and_b32 s63, s42, 0xfff
  s_waitcnt vmcnt(0) lgkmcnt(0)
  s_barrier
  ds_read_b128 v[64:67], v241 offset:0
  ds_read_b128 v[68:71], v241 offset:16
  ds_read_b128 v[72:75], v240 offset:0
  ds_read_b128 v[76:79], v240 offset:2048
  ds_read_b128 v[80:83], v240 offset:4096
  ds_read_b128 v[84:87], v240 offset:6144
  s_waitcnt lgkmcnt(4)
  v_max3_f32 v88, v64, v66, v68
  v_max_f32 v88, v88, v70
  v_sub_f32 v64, v64, v88
  v_sub_f32 v66, v66, v88
  v_sub_f32 v68, v68, v88
  v_sub_f32 v70, v70, v88
  v_exp_f32 v64, v64
  v_exp_f32 v66, v66
  v_exp_f32 v68, v68
  v_exp_f32 v70, v70
  v_mov_b32 v92, v88
  v_mul_f32 v90, v64, v65
  v_fmac_f32 v90, v66, v67
  v_fmac_f32 v90, v68, v69
  v_fmac_f32 v90, v70, v71
  v_mov_b32 v93, s42
  s_waitcnt lgkmcnt(0)
  v_mul_f32 v96, v64, v72
  v_mul_f32 v97, v64, v73
  v_mul_f32 v98, v64, v74
  v_mul_f32 v99, v64, v75
  v_fmac_f32 v96, v66, v76
  v_fmac_f32 v97, v66, v77
  v_fmac_f32 v98, v66, v78
  v_fmac_f32 v99, v66, v79
  v_fmac_f32 v96, v68, v80
  v_fmac_f32 v97, v68, v81
  v_fmac_f32 v98, v68, v82
  v_fmac_f32 v99, v68, v83
  v_fmac_f32 v96, v70, v84
  v_fmac_f32 v97, v70, v85
  v_fmac_f32 v98, v70, v86
  v_fmac_f32 v99, v70, v87
  v_mov_b32 v94, v90
  v_mov_b32 v95, s42
  v_and_or_b32 v96, v96, v26, s63
  v_and_or_b32 v97, v97, v26, s63
  v_and_or_b32 v98, v98, v26, s63
  v_and_or_b32 v99, v99, v26, s63
  global_store_dwordx4 v242, v[96:99], s[28:29] sc1
  s_mov_b32 exec_lo, 0xff
  s_mov_b32 exec_hi, 0xff
  global_store_dwordx4 v243, v[92:95], s[28:29] sc1
  s_mov_b64 exec, -1
  ds_read_b64_tr_b16 v[128:129], v248 offset:0
  ds_read_b64_tr_b16 v[130:131], v248 offset:1024
  ds_read_b64_tr_b16 v[132:133], v248 offset:8192
  ds_read_b64_tr_b16 v[134:135], v248 offset:9216
  ds_read_b64_tr_b16 v[136:137], v248 offset:32
  ds_read_b64_tr_b16 v[138:139], v248 offset:1056
  ds_read_b64_tr_b16 v[140:141], v248 offset:8224
  ds_read_b64_tr_b16 v[142:143], v248 offset:9248
  ds_read_b64_tr_b16 v[144:145], v248 offset:16384
  ds_read_b64_tr_b16 v[146:147], v248 offset:17408
  ds_read_b64_tr_b16 v[148:149], v248 offset:24576
  ds_read_b64_tr_b16 v[150:151], v248 offset:25600
  ds_read_b64_tr_b16 v[152:153], v248 offset:16416
  ds_read_b64_tr_b16 v[154:155], v248 offset:17440
  ds_read_b64_tr_b16 v[156:157], v248 offset:24608
  ds_read_b64_tr_b16 v[158:159], v248 offset:25632
  s_mov_b32 s66, 524288
L_spoll:
  global_load_dwordx4 v[100:103], v244, s[28:29] sc1
  s_waitcnt vmcnt(0)
  v_cmp_eq_u32 vcc, s42, v101
  v_cmp_eq_u32 s[64:65], s42, v103
  s_and_b64 vcc, vcc, s[64:65]
  s_and_b32 s59, vcc_lo, 0x000f000f
  s_and_b32 s60, vcc_hi, 0x000f000f
  s_bcnt1_i32_b32 s59, s59
  s_bcnt1_i32_b32 s60, s60
  s_add_u32 s59, s59, s60
  s_cmp_ge_u32 s59, 15
  s_cbranch_scc1 L_sok
  s_sub_u32 s66, s66, 1
  s_cbranch_scc1 L_sok
  s_sleep 2
  s_branch L_spoll
L_sok:
L_dpoll:
  global_load_dwordx4 v[100:103], v244, s[28:29] sc1
  global_load_dwordx4 v[64:67], v245, s[28:29] offset:0 sc1
  global_load_dwordx4 v[68:71], v245, s[28:29] offset:2048 sc1
  global_load_dwordx4 v[72:75], v246, s[28:29] offset:0 sc1
  global_load_dwordx4 v[76:79], v246, s[28:29] offset:2048 sc1
  s_waitcnt vmcnt(4)
  v_max_f32_dpp v12, v100, v100 row_ror:2 row_mask:0xf bank_mask:0xf
  v_cmp_eq_u32 s[60:61], s42, v101
  s_nop 0
  v_max_f32_dpp v13, v12, v12 row_ror:1 row_mask:0xf bank_mask:0xf
  v_cmp_eq_u32 s[64:65], s42, v103
  v_mov_b32 v12, v13
  s_nop 1
  v_permlane16_swap_b32 v12, v13
  v_max_f32 v13, v13, v12
  v_mov_b32 v16, 0
  v_mov_b32 v12, v13
  s_nop 1
  v_permlane32_swap_b32 v12, v13
  v_max_f32 v13, v13, v12
  v_sub_f32 v14, v100, v13
  v_exp_f32 v14, v14
  v_mov_b32 v17, 0
  v_mul_f32 v15, v14, v102
  v_mov_b32 v8, 0
  v_mov_b32 v9, 0
  v_add_f32_dpp v12, v15, v15 row_ror:2 row_mask:0xf bank_mask:0xf
  s_and_b64 s[60:61], s[60:61], s[64:65]
  s_nop 0
  v_add_f32_dpp v15, v12, v12 row_ror:1 row_mask:0xf bank_mask:0xf
  s_nop 0
  v_mov_b32 v12, v15
  s_nop 1
  v_permlane16_swap_b32 v12, v15
  v_add_f32 v15, v15, v12
  s_nop 0
  v_mov_b32 v12, v15
  s_nop 1
  v_permlane32_swap_b32 v12, v15
  v_add_f32 v15, v15, v12
  v_rcp_f32 v15, v15
  s_nop 0
  v_mul_f32 v14, v14, v15
  s_waitcnt vmcnt(0)
  v_bitop3_b32 v12, v64, v65, v66 bitop3:0x80
  v_or3_b32 v13, v64, v65, v66
  v_bitop3_b32 v12, v12, v67, v68 bitop3:0x80
  v_or3_b32 v13, v13, v67, v68
  v_bitop3_b32 v12, v12, v69, v70 bitop3:0x80
  v_or3_b32 v13, v13, v69, v70
  v_bitop3_b32 v12, v12, v71, v72 bitop3:0x80
  v_or3_b32 v13, v13, v71, v72
  v_bitop3_b32 v12, v12, v73, v74 bitop3:0x80
  v_or3_b32 v13, v13, v73, v74
  v_bitop3_b32 v12, v12, v75, v76 bitop3:0x80
  v_or3_b32 v13, v13, v75, v76
  v_bitop3_b32 v12, v12, v77, v78 bitop3:0x80
  v_or3_b32 v13, v13, v77, v78
  v_and_b32 v12, v12, v79
  v_or_b32 v13, v13, v79
  v_xor_b32 v12, s63, v12
  v_xor_b32 v13, s63, v13
  v_or_b32 v12, v12, v13
  v_and_b32 v12, 0xfff, v12
  v_cmp_eq_u32 vcc, 0, v12
  s_and_b64 vcc, vcc, s[60:61]
  s_cmp_eq_u64 vcc, -1
  s_cbranch_scc1 L_dok
  s_sub_u32 s66, s66, 1
  s_cbranch_scc1 L_dok
  s_branch L_dpoll
L_dok:
  v_fmac_f32_dpp v8, v14, v64 row_newbcast:0 row_mask:0xf bank_mask:0xf
  v_fmac_f32_dpp v9, v14, v65 row_newbcast:0 row_mask:0xf bank_mask:0xf
  v_fmac_f32_dpp v16, v14, v66 row_newbcast:0 row_mask:0xf bank_mask:0xf
  v_fmac_f32_dpp v17, v14, v67 row_newbcast:0 row_mask:0xf bank_mask:0xf
  v_fmac_f32_dpp v8, v14, v68 row_newbcast:1 row_mask:0xf bank_mask:0xf
  v_fmac_f32_dpp v9, v14, v69 row_newbcast:1 row_mask:0xf bank_mask:0xf
  v_fmac_f32_dpp v16, v14, v70 row_newbcast:1 row_mask:0xf bank_mask:0xf
  v_fmac_f32_dpp v17, v14, v71 row_newbcast:1 row_mask:0xf bank_mask:0xf
  v_fmac_f32_dpp v8, v14, v72 row_newbcast:2 row_mask:0xf bank_mask:0xf
  v_fmac_f32_dpp v9, v14, v73 row_newbcast:2 row_mask:0xf bank_mask:0xf
  v_fmac_f32_dpp v16, v14, v74 row_newbcast:2 row_mask:0xf bank_mask:0xf
  v_fmac_f32_dpp v17, v14, v75 row_newbcast:2 row_mask:0xf bank_mask:0xf
  v_fmac_f32_dpp v8, v14, v76 row_newbcast:3 row_mask:0xf bank_mask:0xf
  v_fmac_f32_dpp v9, v14, v77 row_newbcast:3 row_mask:0xf bank_mask:0xf
  v_fmac_f32_dpp v16, v14, v78 row_newbcast:3 row_mask:0xf bank_mask:0xf
  v_fmac_f32_dpp v17, v14, v79 row_newbcast:3 row_mask:0xf bank_mask:0xf
  v_mov_b32 v20, v8
  v_mov_b32 v21, v9
  v_mov_b32 v22, v16
  v_mov_b32 v23, v17
  s_nop 0
  v_permlane16_swap_b32 v20, v8
  v_permlane16_swap_b32 v21, v9
  v_permlane16_swap_b32 v22, v16
  v_permlane16_swap_b32 v23, v17
  v_add_f32 v8, v8, v20
  v_add_f32 v9, v9, v21
  v_add_f32 v16, v16, v22
  v_add_f32 v17, v17, v23
  v_mov_b32 v20, v8
  v_mov_b32 v21, v9
  v_mov_b32 v22, v16
  v_mov_b32 v23, v17
  s_nop 0
  v_permlane32_swap_b32 v20, v8
  v_permlane32_swap_b32 v21, v9
  v_permlane32_swap_b32 v22, v16
  v_permlane32_swap_b32 v23, v17
  v_add_f32 v8, v8, v20
  v_add_f32 v9, v9, v21
  v_add_f32 v16, v16, v22
  v_add_f32 v17, v17, v23
  v_cvt_pk_bf16_f32 v18, v8, v9
  v_cvt_pk_bf16_f32 v19, v16, v17
  ds_write_b16 v247, v18 offset:4608
  ds_write_b16_d16_hi v247, v18 offset:4616
  ds_write_b16 v247, v19 offset:4624
  ds_write_b16_d16_hi v247, v19 offset:4632
  s_waitcnt lgkmcnt(0)
  s_barrier
  ds_read_b128 v[96:99], v249 offset:4608
  ds_read_b128 v[100:103], v249 offset:4672
  ds_read_b128 v[104:107], v249 offset:4864
  ds_read_b128 v[108:111], v249 offset:4928
  s_waitcnt lgkmcnt(0)
  v_mfma_f32_16x16x32_bf16 v[8:11], v[128:131], v[96:99], 0
  v_mfma_f32_16x16x32_bf16 v[12:15], v[136:139], v[96:99], 0
  v_mfma_f32_16x16x32_bf16 v[16:19], v[144:147], v[104:107], 0
  v_mfma_f32_16x16x32_bf16 v[20:23], v[152:155], v[104:107], 0
  v_mfma_f32_16x16x32_bf16 v[8:11], v[132:135], v[100:103], v[8:11]
  v_mfma_f32_16x16x32_bf16 v[12:15], v[140:143], v[100:103], v[12:15]
  v_mfma_f32_16x16x32_bf16 v[16:19], v[148:151], v[108:111], v[16:19]
  v_mfma_f32_16x16x32_bf16 v[20:23], v[156:159], v[108:111], v[20:23]
  s_mov_b32 exec_lo, 0x00030003
  s_mov_b32 exec_hi, 0x00030003
  s_nop 2
  v_and_or_b32 v8, v8, v26, s63
  v_and_or_b32 v9, v9, v26, s63
  v_and_or_b32 v10, v10, v26, s63
  v_and_or_b32 v11, v11, v26, s63
  v_and_or_b32 v12, v12, v26, s63
  v_and_or_b32 v13, v13, v26, s63
  v_and_or_b32 v14, v14, v26, s63
  v_and_or_b32 v15, v15, v26, s63
  v_and_or_b32 v16, v16, v26, s63
  v_and_or_b32 v17, v17, v26, s63
  v_and_or_b32 v18, v18, v26, s63
  v_and_or_b32 v19, v19, v26, s63
  v_and_or_b32 v20, v20, v26, s63
  v_and_or_b32 v21, v21, v26, s63
  v_and_or_b32 v22, v22, v26, s63
  v_and_or_b32 v23, v23, v26, s63
  global_store_dwordx4 v250, v[8:11], s[28:29] sc1
  global_store_dwordx4 v253, v[12:15], s[28:29] sc1
  global_store_dwordx4 v254, v[16:19], s[28:29] sc1
  global_store_dwordx4 v255, v[20:23], s[28:29] sc1
  s_mov_b64 exec, -1
  s_cmp_lg_u32 s3, 0
  s_cbranch_scc1 L_end
  s_cmp_ge_u32 s2, 64
  s_cbranch_scc1 L_fin
  s_mov_b32 s66, 524288
  v_add_u32 v6, 4096, v251
L_opoll:
  global_load_dwordx4 v[64:67], v251, s[28:29] offset:0 sc1
  global_load_dwordx4 v[68:71], v251, s[28:29] offset:1024 sc1
  global_load_dwordx4 v[72:75], v251, s[28:29] offset:2048 sc1
  global_load_dwordx4 v[76:79], v251, s[28:29] offset:3072 sc1
  global_load_dwordx4 v[80:83], v6, s[28:29] offset:0 sc1
  global_load_dwordx4 v[84:87], v6, s[28:29] offset:1024 sc1
  global_load_dwordx4 v[88:91], v6, s[28:29] offset:2048 sc1
  global_load_dwordx4 v[92:95], v6, s[28:29] offset:3072 sc1
  s_waitcnt vmcnt(0)
  v_bitop3_b32 v12, v64, v65, v66 bitop3:0x80
  v_or3_b32 v13, v64, v65, v66
  v_bitop3_b32 v12, v12, v67, v68 bitop3:0x80
  v_or3_b32 v13, v13, v67, v68
  v_bitop3_b32 v12, v12, v69, v70 bitop3:0x80
  v_or3_b32 v13, v13, v69, v70
  v_bitop3_b32 v12, v12, v71, v72 bitop3:0x80
  v_or3_b32 v13, v13, v71, v72
  v_bitop3_b32 v12, v12, v73, v74 bitop3:0x80
  v_or3_b32 v13, v13, v73, v74
  v_bitop3_b32 v12, v12, v75, v76 bitop3:0x80
  v_or3_b32 v13, v13, v75, v76
  v_bitop3_b32 v12, v12, v77, v78 bitop3:0x80
  v_or3_b32 v13, v13, v77, v78
  v_bitop3_b32 v12, v12, v79, v80 bitop3:0x80
  v_or3_b32 v13, v13, v79, v80
  v_bitop3_b32 v12, v12, v81, v82 bitop3:0x80
  v_or3_b32 v13, v13, v81, v82
  v_bitop3_b32 v12, v12, v83, v84 bitop3:0x80
  v_or3_b32 v13, v13, v83, v84
  v_bitop3_b32 v12, v12, v85, v86 bitop3:0x80
  v_or3_b32 v13, v13, v85, v86
  v_bitop3_b32 v12, v12, v87, v88 bitop3:0x80
  v_or3_b32 v13, v13, v87, v88
  v_bitop3_b32 v12, v12, v89, v90 bitop3:0x80
  v_or3_b32 v13, v13, v89, v90
  v_bitop3_b32 v12, v12, v91, v92 bitop3:0x80
  v_or3_b32 v13, v13, v91, v92
  v_bitop3_b32 v12, v12, v93, v94 bitop3:0x80
  v_or3_b32 v13, v13, v93, v94
  v_and_b32 v12, v12, v95
  v_or_b32 v13, v13, v95
  v_xor_b32 v12, s63, v12
  v_xor_b32 v13, s63, v13
  v_or_b32 v12, v12, v13
  v_and_b32 v12, 0xfff, v12
  v_cmp_eq_u32 vcc, 0, v12
  s_cmp_eq_u64 vcc, -1
  s_cbranch_scc1 L_ook
  s_sub_u32 s66, s66, 1
  s_cbranch_scc1 L_ook
  s_branch L_opoll
L_ook:
  v_add_f32 v64, v64, v68
  v_add_f32 v72, v72, v76
  v_add_f32 v80, v80, v84
  v_add_f32 v88, v88, v92
  v_add_f32 v65, v65, v69
  v_add_f32 v73, v73, v77
  v_add_f32 v81, v81, v85
  v_add_f32 v89, v89, v93
  v_add_f32 v66, v66, v70
  v_add_f32 v74, v74, v78
  v_add_f32 v82, v82, v86
  v_add_f32 v90, v90, v94
  v_add_f32 v67, v67, v71
  v_add_f32 v75, v75, v79
  v_add_f32 v83, v83, v87
  v_add_f32 v91, v91, v95
  v_add_f32 v64, v64, v72
  v_add_f32 v80, v80, v88
  v_add_f32 v65, v65, v73
  v_add_f32 v81, v81, v89
  v_add_f32 v66, v66, v74
  v_add_f32 v82, v82, v90
  v_add_f32 v67, v67, v75
  v_add_f32 v83, v83, v91
  v_add_f32 v64, v64, v80
  v_add_f32 v65, v65, v81
  v_add_f32 v66, v66, v82
  v_add_f32 v67, v67, v83
  s_nop 0
  v_add_f32_dpp v68, v64, v64 row_ror:8 row_mask:0xf bank_mask:0xf
  v_add_f32_dpp v69, v65, v65 row_ror:8 row_mask:0xf bank_mask:0xf
  v_add_f32_dpp v70, v66, v66 row_ror:8 row_mask:0xf bank_mask:0xf
  v_add_f32_dpp v71, v67, v67 row_ror:8 row_mask:0xf bank_mask:0xf
  v_mov_b32 v72, v68
  v_mov_b32 v73, v69
  v_mov_b32 v74, v70
  v_mov_b32 v75, v71
  s_nop 0
  v_permlane16_swap_b32 v72, v68
  v_permlane16_swap_b32 v73, v69
  v_permlane16_swap_b32 v74, v70
  v_permlane16_swap_b32 v75, v71
  v_add_f32 v68, v68, v72
  v_add_f32 v69, v69, v73
  v_add_f32 v70, v70, v74
  v_add_f32 v71, v71, v75
  v_mov_b32 v72, v68
  v_mov_b32 v73, v69
  v_mov_b32 v74, v70
  v_mov_b32 v75, v71
  s_nop 0
  v_permlane32_swap_b32 v72, v68
  v_permlane32_swap_b32 v73, v69
  v_permlane32_swap_b32 v74, v70
  v_permlane32_swap_b32 v75, v71
  v_add_f32 v68, v68, v72
  v_add_f32 v69, v69, v73
  v_add_f32 v70, v70, v74
  v_add_f32 v71, v71, v75
  v_cvt_pk_bf16_f32 v64, v68, v69
  v_cvt_pk_bf16_f32 v65, v70, v71
  s_mov_b64 exec, 0xff
  global_store_dwordx2 v252, v[64:65], s[24:25]
  s_mov_b64 exec, -1
  s_cmp_lg_u32 s2, 0
  s_cbranch_scc1 L_fin
  s_add_u32 s59, s43, 1
  v_mov_b32 v7, s59
  v_mov_b32 v8, 0
  s_mov_b64 exec, 1
  global_store_dword v8, v7, s[28:29] offset:0 sc1
  s_mov_b64 exec, -1
L_fin:
L_end:
  s_endpgm
.section .rodata,"a"
.p2align 6
.amdhsa_kernel concat_heads__gqa_block_cached__sliding_block_cached__decode_kernel
  .amdhsa_next_free_vgpr 256
  .amdhsa_next_free_sgpr 102
  .amdhsa_accum_offset 256
  .amdhsa_group_segment_fixed_size 0
  .amdhsa_kernarg_size 104
  .amdhsa_user_sgpr_count 2
  .amdhsa_user_sgpr_kernarg_segment_ptr 1
  .amdhsa_system_sgpr_workgroup_id_x 1
.end_amdhsa_kernel
```
